```python
import torch

def _softmax(x, axis=-1):
    return torch.softmax(x, dim=axis)
def _gelu(x):
    return torch.nn.functional.gelu(x, approximate="tanh")
def _silu(x):
    return torch.nn.functional.silu(x)
def _sigmoid(x):
    return torch.sigmoid(x)
def _layernorm(x, axis=-1, eps=1e-5):
    m = x.mean(dim=axis, keepdim=True)
    v = x.var(dim=axis, keepdim=True, unbiased=False)
    return (x - m) / torch.sqrt(v + eps)
def _scatter_add(tgt, idx, src, axis=0):
    return tgt.clone().index_add_(axis, idx, src)
def _segment_sum(src, seg, n):
    out = torch.zeros((n,) + src.shape[1:], dtype=src.dtype)
    return out.index_add_(0, seg, src)
def _pad(x, pw):
    flat = tuple(v for pair in reversed(pw) for v in pair)
    return torch.nn.functional.pad(x, flat)

kernel_name = 'standalone__mha_block__prompt'

def setup_inputs():

    _w = (lambda a: (lambda t: t.to(torch.bfloat16) if t.is_floating_point() else t)(torch.as_tensor(a)))
    B, S, D, H = 1, 2048, 512, 32
    return {
        "x": _w((lambda *s: torch.randn(*s, dtype=torch.bfloat16) * 0.2)(B, S, D)),
        "wqkv": _w((lambda *s: torch.randn(*s, dtype=torch.bfloat16) * 0.2)(D, 3 * D)),
        "wo": _w((lambda *s: torch.randn(*s, dtype=torch.bfloat16) * 0.05)(D, D)),
    }

def reference(x, wqkv, wo):
    B, S, D = x.shape
    H = 32
    Dh = D // H
    qkv = (lambda x, *d: x.permute(*d))((x @ wqkv).reshape(B, S, 3, H, Dh), 2, 0, 3, 1, 4)
    q, k, v = qkv[0], qkv[1], qkv[2]
    scores = torch.einsum("bhqd,bhkd->bhqk", q, k) * (Dh ** -0.5)
    p = _softmax(scores, axis=-1)
    o = torch.einsum("bhqk,bhkd->bhqd", p, v)
    return (lambda x, *d: x.permute(*d))(o, 0, 2, 1, 3).reshape(B, S, D) @ wo
```

```asm
; @launch grid=(256,1,1) block=(512,1,1) lds=163840
.amdgcn_target "amdgcn-amd-amdhsa--gfx950"
.text
.globl standalone__mha_block__prompt_kernel
.p2align 8
.type standalone__mha_block__prompt_kernel,@function
standalone__mha_block__prompt_kernel:
    s_cmp_ge_u32 s2, 256
    s_cbranch_scc1 L_end
    s_load_dwordx2 s[12:13], s[0:1], 0
    s_load_dwordx2 s[16:17], s[0:1], 8
    s_load_dwordx2 s[32:33], s[0:1], 32
    s_load_dwordx2 s[20:21], s[0:1], 40
    s_load_dwordx2 s[24:25], s[0:1], 16
    s_load_dwordx2 s[28:29], s[0:1], 24
    s_memrealtime s[46:47]
    s_getpc_b64 s[76:77]
L_pc:
    v_lshlrev_b32 v1, 7, v0
    v_cmp_gt_u32 vcc, (L_codeend-L_pc)/128, v0
    s_and_saveexec_b64 s[78:79], vcc
    s_cbranch_execz L_noipf
    global_load_dword v251, v1, s[76:77]
L_noipf:
    s_mov_b64 exec, -1
    v_lshrrev_b32 v1, 6, v0
    v_and_b32 v0, 63, v0
    v_readfirstlane_b32 s42, v1
    s_and_b32 s54, s2, 3
    s_lshl_b32 s54, s54, 1
    s_bfe_u32 s55, s2, 0x10003
    s_add_u32 s40, s54, s55
    s_bfe_u32 s54, s2, 0x10002
    s_lshl_b32 s54, s54, 4
    s_lshr_b32 s55, s2, 4
    s_add_u32 s41, s54, s55
    s_and_b32 s43, s42, 3
    s_lshr_b32 s44, s42, 2
    s_lshl_b32 s52, s42, 10
    v_lshlrev_b32 v2, 4, v0
    v_lshrrev_b32 v10, 3, v0
    v_and_b32 v11, 7, v0
    v_lshrrev_b32 v12, 4, v0
    s_and_b32 s53, s42, 1
    s_lshl_b32 s54, s53, 2
    v_xor_b32 v13, v11, v12
    v_xor_b32 v13, s54, v13
    s_lshl_b32 s55, s42, 3
    v_add_u32 v10, s55, v10
    s_lshl_b32 s55, s41, 16
    v_lshlrev_b32 v14, 10, v10
    v_lshl_add_u32 v14, v13, 4, v14
    v_add_u32 v4, s55, v14
    v_and_b32 v12, 1, v12
    v_lshlrev_b32 v12, 1, v12
    v_xor_b32 v13, v11, v12
    v_xor_b32 v13, s54, v13
    v_mul_u32_u24 v14, 3072, v10
    v_lshl_add_u32 v14, v13, 4, v14
    s_lshl_b32 s55, s40, 7
    v_add_u32 v5, s55, v14
    s_add_u32 s53, s40, s41
    s_and_b32 s53, s53, 7
    s_lshl_b32 s84, s53, 7
    s_mul_i32 s92, s53, 196608
    s_add_u32 s53, s53, 1
    s_and_b32 s53, s53, 7
    s_lshl_b32 s85, s53, 7
    s_mul_i32 s93, s53, 196608
    s_add_u32 s53, s53, 1
    s_and_b32 s53, s53, 7
    s_lshl_b32 s86, s53, 7
    s_mul_i32 s94, s53, 196608
    s_add_u32 s53, s53, 1
    s_and_b32 s53, s53, 7
    s_lshl_b32 s87, s53, 7
    s_mul_i32 s95, s53, 196608
    s_add_u32 s53, s53, 1
    s_and_b32 s53, s53, 7
    s_lshl_b32 s88, s53, 7
    s_mul_i32 s96, s53, 196608
    s_add_u32 s53, s53, 1
    s_and_b32 s53, s53, 7
    s_lshl_b32 s89, s53, 7
    s_mul_i32 s97, s53, 196608
    s_add_u32 s53, s53, 1
    s_and_b32 s53, s53, 7
    s_lshl_b32 s90, s53, 7
    s_mul_i32 s98, s53, 196608
    s_add_u32 s53, s53, 1
    s_and_b32 s53, s53, 7
    s_lshl_b32 s91, s53, 7
    s_mul_i32 s99, s53, 196608
    v_and_b32 v12, 31, v0
    s_lshl_b32 s53, s41, 5
    s_and_b32 s53, s53, 511
    v_add_u32 v12, s53, v12
    v_mul_u32_u24 v15, 3072, v12
    s_mov_b32 s14, 0x200000
    s_mov_b32 s15, 0x00020000
    s_mov_b32 s18, 0x180000
    s_mov_b32 s19, 0x00020000
    s_mov_b32 s34, 0x100
    s_mov_b32 s35, 0x00020000
    s_mov_b32 s22, 0x800000
    s_mov_b32 s23, 0x00020000
    s_mov_b32 s26, 0x80000
    s_mov_b32 s27, 0x00020000
    s_mov_b32 s30, 0x200000
    s_mov_b32 s31, 0x00020000
    s_mov_b32 m0, s52
    s_waitcnt lgkmcnt(0)
    buffer_load_dwordx4 v4, s[12:15], s84 offen lds
    s_add_u32 m0, s52, 64512
    s_nop 0
    buffer_load_dwordx4 v5, s[16:19], s92 offen offset:1024 lds
    s_add_u32 m0, s52, 71680
    s_nop 0
    buffer_load_dwordx4 v5, s[16:19], s92 offen offset:2048 lds
    s_or_b32 s46, s46, 1
    s_or_b32 s53, s2, s42
    s_cbranch_scc1 L_nonon
    v_mov_b32 v10, s46
    v_mov_b32 v11, s47
    s_mov_b64 exec, 1
    buffer_store_dwordx2 v[10:11], off, s[32:35], 0 sc1
    s_mov_b64 exec, -1
L_nonon:
    s_cmp_lg_u32 s42, 7
    s_cbranch_scc1 L_noqpf
    buffer_load_dword v250, v15, s[16:19], s55 offen
L_noqpf:
    s_add_u32 m0, s52, 8192
    s_nop 0
    buffer_load_dwordx4 v4, s[12:15], s85 offen lds
    s_add_u32 m0, s52, 16384
    s_nop 0
    buffer_load_dwordx4 v4, s[12:15], s86 offen lds
    s_add_u32 m0, s52, 24576
    s_nop 0
    buffer_load_dwordx4 v4, s[12:15], s87 offen lds
    s_lshl_b32 s45, s42, 12
    s_add_u32 s45, s45, 131072
    s_lshl_b32 s53, s40, 2
    s_add_u32 s56, s53, s43
    s_mul_i32 s53, s56, 131072
    s_lshl_b32 s54, s44, 11
    s_add_u32 s51, s53, s54
    s_lshl_b32 s64, s41, 12
    s_add_u32 s50, s51, s64
    s_lshl_b32 s53, s41, 1
    s_add_u32 s57, s53, s44
    s_lshl_b32 s53, s57, 15
    s_lshl_b32 s54, s56, 10
    s_add_u32 s58, s53, s54
    s_add_u32 s58, s58, 0x500000
    s_lshl_b32 s63, s40, 10
    s_add_u32 s63, s63, 0x700000
    v_and_b32 v12, 31, v0
    v_lshlrev_b32 v242, 5, v12
    s_lshr_b32 s53, s40, 2
    s_lshl_b32 s54, s41, 1
    s_add_u32 s60, s53, s54
    s_add_u32 s61, s40, s41
    s_and_b32 s61, s61, 3
    s_lshl_b32 s61, s61, 8
    s_lshl_b32 s53, s60, 15
    s_add_u32 s62, s53, s61
    s_lshl_b32 s53, s43, 6
    s_add_u32 s62, s62, s53
    s_lshl_b32 s53, s44, 14
    s_add_u32 s62, s62, s53
    s_lshl_b32 s53, s41, 3
    s_add_u32 s54, s53, s40
    s_lshl_b32 s54, s54, 10
    s_add_u32 s74, s54, 0x740000
    s_add_u32 s75, s53, s42
    s_lshl_b32 s75, s75, 10
    s_lshl_b32 s54, s40, 7
    s_add_u32 s75, s75, s54
    s_add_u32 s75, s75, 0x740000
    s_lshl_b32 s65, s41, 13
    s_and_b32 s65, s65, 0x1ffff
    s_lshl_b32 s66, s65, 2
    v_and_b32 v10, 15, v0
    v_lshrrev_b32 v11, 4, v0
    v_bfe_u32 v12, v0, 1, 3
    v_xor_b32 v12, v11, v12
    s_lshl_b32 s53, s44, 12
    v_lshlrev_b32 v13, 7, v10
    v_add_u32 v13, s53, v13
    v_lshl_add_u32 v6, v12, 4, v13
    v_xor_b32 v7, 64, v6
    v_bfe_u32 v12, v0, 2, 2
    v_lshl_add_u32 v13, v11, 3, v12
    v_lshlrev_b32 v13, 7, v13
    v_bfe_u32 v14, v0, 3, 2
    v_xor_b32 v14, s43, v14
    v_lshl_add_u32 v13, v14, 5, v13
    v_and_b32 v14, 3, v0
    v_lshl_add_u32 v249, v14, 3, v13
    v_add_u32 v8, 65536, v249
    v_add_u32 v254, 131072, v249
    v_lshrrev_b32 v12, 5, v0
    v_lshlrev_b32 v12, 8, v12
    v_lshl_add_u32 v12, v10, 4, v12
    v_add_u32 v9, 1024, v12
    v_add_u32 v247, s51, v2
    v_add_u32 v248, s51, v9
    v_and_b32 v12, 0x23, v0
    v_bfe_u32 v13, v0, 2, 2
    v_lshl_add_u32 v12, v13, 3, v12
    v_bfe_u32 v13, v0, 4, 1
    v_lshl_add_u32 v12, v13, 2, v12
    v_lshlrev_b32 v246, 4, v12
    s_lshl_b32 s53, s42, 2
    v_add_u32 v12, s53, v11
    v_and_b32 v13, 7, v12
    v_lshlrev_b32 v13, 1, v13
    v_xor_b32 v13, v10, v13
    v_lshlrev_b32 v14, 10, v12
    v_lshl_add_u32 v14, v13, 4, v14
    v_add_u32 v240, s61, v14
    v_mov_b32 v3, 0xdddddddd
    s_mov_b32 s48, 0xffff
    s_mov_b32 s49, 0xffff
    v_and_b32 v12, 27, v0
    v_cmp_eq_u32 vcc, 16, v12
    v_mov_b32 v15, 0x3f803f80
    s_nop 0
    v_cndmask_b32 v60, 0, v15, vcc
    v_cndmask_b32 v61, 0, v15, vcc
    v_cndmask_b32 v62, 0, v15, vcc
    v_cndmask_b32 v63, 0, v15, vcc
    v_cndmask_b32 v64, 0, v15, vcc
    v_cndmask_b32 v65, 0, v15, vcc
    v_cndmask_b32 v66, 0, v15, vcc
    v_cndmask_b32 v67, 0, v15, vcc
    v_cndmask_b32 v72, 0, v15, vcc
    v_cndmask_b32 v73, 0, v15, vcc
    v_cndmask_b32 v74, 0, v15, vcc
    v_cndmask_b32 v75, 0, v15, vcc
    v_cndmask_b32 v76, 0, v15, vcc
    v_cndmask_b32 v77, 0, v15, vcc
    v_cndmask_b32 v78, 0, v15, vcc
    v_cndmask_b32 v79, 0, v15, vcc
    v_cndmask_b32 v84, 0, v15, vcc
    v_cndmask_b32 v85, 0, v15, vcc
    v_cndmask_b32 v86, 0, v15, vcc
    v_cndmask_b32 v87, 0, v15, vcc
    v_cndmask_b32 v88, 0, v15, vcc
    v_cndmask_b32 v89, 0, v15, vcc
    v_cndmask_b32 v90, 0, v15, vcc
    v_cndmask_b32 v91, 0, v15, vcc
    v_cndmask_b32 v96, 0, v15, vcc
    v_cndmask_b32 v97, 0, v15, vcc
    v_cndmask_b32 v98, 0, v15, vcc
    v_cndmask_b32 v99, 0, v15, vcc
    v_cndmask_b32 v100, 0, v15, vcc
    v_cndmask_b32 v101, 0, v15, vcc
    v_cndmask_b32 v102, 0, v15, vcc
    v_cndmask_b32 v103, 0, v15, vcc
    s_add_u32 m0, s52, 80896
    s_nop 0
    buffer_load_dwordx4 v5, s[16:19], s93 offen offset:1024 lds
    s_add_u32 m0, s52, 88064
    s_nop 0
    buffer_load_dwordx4 v5, s[16:19], s93 offen offset:2048 lds
    s_add_u32 m0, s52, 97280
    s_nop 0
    buffer_load_dwordx4 v5, s[16:19], s94 offen offset:1024 lds
    s_add_u32 m0, s52, 104448
    s_nop 0
    buffer_load_dwordx4 v5, s[16:19], s94 offen offset:2048 lds
    s_waitcnt vmcnt(7)
    s_barrier
    ds_read_b128 v[112:115], v6 offset:0
    ds_read_b128 v[116:119], v6 offset:2048
    ds_read_b64_tr_b16 v[40:41], v8 offset:0
    ds_read_b64_tr_b16 v[42:43], v8 offset:512
    s_add_u32 m0, s52, 113664
    s_nop 0
    buffer_load_dwordx4 v5, s[16:19], s95 offen offset:1024 lds
    ds_read_b64_tr_b16 v[44:45], v8 offset:8192
    ds_read_b64_tr_b16 v[46:47], v8 offset:8704
    ds_read_b128 v[120:123], v7 offset:0
    ds_read_b128 v[124:127], v7 offset:2048
    s_add_u32 m0, s52, 120832
    s_nop 0
    buffer_load_dwordx4 v5, s[16:19], s95 offen offset:2048 lds
    ds_read_b64_tr_b16 v[48:49], v8 offset:4096
    ds_read_b64_tr_b16 v[50:51], v8 offset:4608
    ds_read_b64_tr_b16 v[52:53], v8 offset:12288
    ds_read_b64_tr_b16 v[54:55], v8 offset:12800
    s_add_u32 m0, s52, 32768
    s_nop 0
    buffer_load_dwordx4 v4, s[12:15], s88 offen lds
    s_waitcnt vmcnt(5)
    s_barrier
    s_waitcnt lgkmcnt(0)
    ds_read_b128 v[128:131], v6 offset:8192
    ds_read_b128 v[132:135], v6 offset:10240
    v_mfma_f32_16x16x32_bf16 v[16:19], v[40:43], v[112:115], 0
    ds_read_b64_tr_b16 v[32:33], v8 offset:16384
    v_mfma_f32_16x16x32_bf16 v[20:23], v[40:43], v[116:119], 0
    ds_read_b64_tr_b16 v[34:35], v8 offset:16896
    s_add_u32 m0, s52, 130048
    s_nop 0
    buffer_load_dwordx4 v5, s[16:19], s96 offen offset:1024 lds
    ds_read_b64_tr_b16 v[36:37], v8 offset:24576
    v_mfma_f32_16x16x32_bf16 v[24:27], v[112:115], v[44:47], 0
    ds_read_b64_tr_b16 v[38:39], v8 offset:25088
    v_mfma_f32_16x16x32_bf16 v[28:31], v[116:119], v[44:47], 0
    ds_read_b128 v[136:139], v7 offset:8192
    ds_read_b128 v[140:143], v7 offset:10240
    v_mfma_f32_16x16x32_bf16 v[16:19], v[48:51], v[120:123], v[16:19]
    s_add_u32 m0, s52, 137216
    s_nop 0
    buffer_load_dwordx4 v5, s[16:19], s96 offen offset:2048 lds
    ds_read_b64_tr_b16 v[104:105], v8 offset:20480
    v_mfma_f32_16x16x32_bf16 v[20:23], v[48:51], v[124:127], v[20:23]
    ds_read_b64_tr_b16 v[106:107], v8 offset:20992
    ds_read_b64_tr_b16 v[108:109], v8 offset:28672
    v_mfma_f32_16x16x32_bf16 v[24:27], v[120:123], v[52:55], v[24:27]
    ds_read_b64_tr_b16 v[110:111], v8 offset:29184
    v_mfma_f32_16x16x32_bf16 v[28:31], v[124:127], v[52:55], v[28:31]
    s_add_u32 m0, s52, 40960
    s_nop 0
    buffer_load_dwordx4 v4, s[12:15], s89 offen lds
    s_waitcnt vmcnt(6)
    s_barrier
    s_waitcnt lgkmcnt(0)
    ds_read_b128 v[144:147], v6 offset:16384
    ds_read_b128 v[148:151], v6 offset:18432
    v_mfma_f32_16x16x32_bf16 v[16:19], v[32:35], v[128:131], v[16:19]
    ds_read_b64_tr_b16 v[40:41], v8 offset:32768
    v_mfma_f32_16x16x32_bf16 v[20:23], v[32:35], v[132:135], v[20:23]
    ds_read_b64_tr_b16 v[42:43], v8 offset:33280
    s_add_u32 m0, s52, 64512
    s_nop 0
    buffer_load_dwordx4 v5, s[16:19], s97 offen offset:1024 lds
    ds_read_b64_tr_b16 v[44:45], v8 offset:40960
    v_mfma_f32_16x16x32_bf16 v[24:27], v[128:131], v[36:39], v[24:27]
    ds_read_b64_tr_b16 v[46:47], v8 offset:41472
    v_mfma_f32_16x16x32_bf16 v[28:31], v[132:135], v[36:39], v[28:31]
    ds_read_b128 v[152:155], v7 offset:16384
    ds_read_b128 v[156:159], v7 offset:18432
    v_mfma_f32_16x16x32_bf16 v[16:19], v[104:107], v[136:139], v[16:19]
    s_add_u32 m0, s52, 71680
    s_nop 0
    buffer_load_dwordx4 v5, s[16:19], s97 offen offset:2048 lds
    ds_read_b64_tr_b16 v[48:49], v8 offset:36864
    v_mfma_f32_16x16x32_bf16 v[20:23], v[104:107], v[140:143], v[20:23]
    ds_read_b64_tr_b16 v[50:51], v8 offset:37376
    ds_read_b64_tr_b16 v[52:53], v8 offset:45056
    v_mfma_f32_16x16x32_bf16 v[24:27], v[136:139], v[108:111], v[24:27]
    ds_read_b64_tr_b16 v[54:55], v8 offset:45568
    v_mfma_f32_16x16x32_bf16 v[28:31], v[140:143], v[108:111], v[28:31]
    s_add_u32 m0, s52, 49152
    s_nop 0
    buffer_load_dwordx4 v4, s[12:15], s90 offen lds
    s_cmp_lg_u32 s42, 0
    s_cbranch_scc1 L_nf1
    buffer_load_dwordx2 v[244:245], off, s[32:35], 0 sc1
L_nf1:
    s_waitcnt vmcnt(7)
    s_barrier
    s_waitcnt lgkmcnt(0)
    ds_read_b128 v[160:163], v6 offset:24576
    ds_read_b128 v[164:167], v6 offset:26624
    v_mfma_f32_16x16x32_bf16 v[16:19], v[40:43], v[144:147], v[16:19]
    ds_read_b64_tr_b16 v[32:33], v8 offset:49152
    v_mfma_f32_16x16x32_bf16 v[20:23], v[40:43], v[148:151], v[20:23]
    ds_read_b64_tr_b16 v[34:35], v8 offset:49664
    s_add_u32 m0, s52, 80896
    s_nop 0
    buffer_load_dwordx4 v5, s[16:19], s98 offen offset:1024 lds
    ds_read_b64_tr_b16 v[36:37], v8 offset:57344
    v_mfma_f32_16x16x32_bf16 v[24:27], v[144:147], v[44:47], v[24:27]
    ds_read_b64_tr_b16 v[38:39], v8 offset:57856
    v_mfma_f32_16x16x32_bf16 v[28:31], v[148:151], v[44:47], v[28:31]
    ds_read_b128 v[168:171], v7 offset:24576
    ds_read_b128 v[172:175], v7 offset:26624
    v_mfma_f32_16x16x32_bf16 v[16:19], v[48:51], v[152:155], v[16:19]
    s_add_u32 m0, s52, 88064
    s_nop 0
    buffer_load_dwordx4 v5, s[16:19], s98 offen offset:2048 lds
    ds_read_b64_tr_b16 v[104:105], v8 offset:53248
    v_mfma_f32_16x16x32_bf16 v[20:23], v[48:51], v[156:159], v[20:23]
    ds_read_b64_tr_b16 v[106:107], v8 offset:53760
    ds_read_b64_tr_b16 v[108:109], v8 offset:61440
    v_mfma_f32_16x16x32_bf16 v[24:27], v[152:155], v[52:55], v[24:27]
    ds_read_b64_tr_b16 v[110:111], v8 offset:61952
    v_mfma_f32_16x16x32_bf16 v[28:31], v[156:159], v[52:55], v[28:31]
    s_add_u32 m0, s52, 57344
    s_nop 0
    buffer_load_dwordx4 v4, s[12:15], s91 offen lds
    s_waitcnt vmcnt(7)
    s_barrier
    s_waitcnt lgkmcnt(0)
    ds_read_b128 v[176:179], v6 offset:32768
    ds_read_b128 v[180:183], v6 offset:34816
    v_mfma_f32_16x16x32_bf16 v[16:19], v[32:35], v[160:163], v[16:19]
    ds_read_b64_tr_b16 v[40:41], v254 offset:0
    v_mfma_f32_16x16x32_bf16 v[20:23], v[32:35], v[164:167], v[20:23]
    ds_read_b64_tr_b16 v[42:43], v254 offset:512
    s_add_u32 m0, s52, 97280
    s_nop 0
    buffer_load_dwordx4 v5, s[16:19], s99 offen offset:1024 lds
    ds_read_b64_tr_b16 v[44:45], v254 offset:8192
    v_mfma_f32_16x16x32_bf16 v[24:27], v[160:163], v[36:39], v[24:27]
    ds_read_b64_tr_b16 v[46:47], v254 offset:8704
    v_mfma_f32_16x16x32_bf16 v[28:31], v[164:167], v[36:39], v[28:31]
    ds_read_b128 v[184:187], v7 offset:32768
    ds_read_b128 v[188:191], v7 offset:34816
    v_mfma_f32_16x16x32_bf16 v[16:19], v[104:107], v[168:171], v[16:19]
    s_add_u32 m0, s52, 104448
    s_nop 0
    buffer_load_dwordx4 v5, s[16:19], s99 offen offset:2048 lds
    ds_read_b64_tr_b16 v[48:49], v254 offset:4096
    v_mfma_f32_16x16x32_bf16 v[20:23], v[104:107], v[172:175], v[20:23]
    ds_read_b64_tr_b16 v[50:51], v254 offset:4608
    ds_read_b64_tr_b16 v[52:53], v254 offset:12288
    v_mfma_f32_16x16x32_bf16 v[24:27], v[168:171], v[108:111], v[24:27]
    ds_read_b64_tr_b16 v[54:55], v254 offset:12800
    v_mfma_f32_16x16x32_bf16 v[28:31], v[172:175], v[108:111], v[28:31]
    s_waitcnt vmcnt(6)
    s_barrier
    s_waitcnt lgkmcnt(0)
    ds_read_b128 v[192:195], v6 offset:40960
    ds_read_b128 v[196:199], v6 offset:43008
    v_mfma_f32_16x16x32_bf16 v[16:19], v[40:43], v[176:179], v[16:19]
    ds_read_b64_tr_b16 v[32:33], v8 offset:0
    v_mfma_f32_16x16x32_bf16 v[20:23], v[40:43], v[180:183], v[20:23]
    ds_read_b64_tr_b16 v[34:35], v8 offset:512
    s_add_u32 m0, s52, 0
    s_nop 0
    buffer_load_dwordx4 v5, s[16:19], s92 offen offset:0 lds
    ds_read_b64_tr_b16 v[36:37], v8 offset:8192
    v_mfma_f32_16x16x32_bf16 v[24:27], v[176:179], v[44:47], v[24:27]
    ds_read_b64_tr_b16 v[38:39], v8 offset:8704
    v_mfma_f32_16x16x32_bf16 v[28:31], v[180:183], v[44:47], v[28:31]
    ds_read_b128 v[200:203], v7 offset:40960
    ds_read_b128 v[204:207], v7 offset:43008
    v_mfma_f32_16x16x32_bf16 v[16:19], v[48:51], v[184:187], v[16:19]
    s_add_u32 m0, s52, 8192
    s_nop 0
    buffer_load_dwordx4 v5, s[16:19], s93 offen offset:0 lds
    ds_read_b64_tr_b16 v[104:105], v8 offset:4096
    v_mfma_f32_16x16x32_bf16 v[20:23], v[48:51], v[188:191], v[20:23]
    ds_read_b64_tr_b16 v[106:107], v8 offset:4608
    ds_read_b64_tr_b16 v[108:109], v8 offset:12288
    v_mfma_f32_16x16x32_bf16 v[24:27], v[184:187], v[52:55], v[24:27]
    ds_read_b64_tr_b16 v[110:111], v8 offset:12800
    v_mfma_f32_16x16x32_bf16 v[28:31], v[188:191], v[52:55], v[28:31]
    s_add_u32 m0, s52, 16384
    s_nop 0
    buffer_load_dwordx4 v5, s[16:19], s94 offen offset:0 lds
    s_waitcnt vmcnt(6)
    s_barrier
    s_waitcnt lgkmcnt(0)
    ds_read_b128 v[208:211], v6 offset:49152
    ds_read_b128 v[212:215], v6 offset:51200
    v_mfma_f32_16x16x32_bf16 v[16:19], v[32:35], v[192:195], v[16:19]
    ds_read_b64_tr_b16 v[40:41], v8 offset:16384
    v_mfma_f32_16x16x32_bf16 v[20:23], v[32:35], v[196:199], v[20:23]
    ds_read_b64_tr_b16 v[42:43], v8 offset:16896
    s_add_u32 m0, s52, 24576
    s_nop 0
    buffer_load_dwordx4 v5, s[16:19], s95 offen offset:0 lds
    ds_read_b64_tr_b16 v[44:45], v8 offset:24576
    v_mfma_f32_16x16x32_bf16 v[24:27], v[192:195], v[36:39], v[24:27]
    ds_read_b64_tr_b16 v[46:47], v8 offset:25088
    v_mfma_f32_16x16x32_bf16 v[28:31], v[196:199], v[36:39], v[28:31]
    ds_read_b128 v[216:219], v7 offset:49152
    ds_read_b128 v[220:223], v7 offset:51200
    v_mfma_f32_16x16x32_bf16 v[16:19], v[104:107], v[200:203], v[16:19]
    s_add_u32 m0, s52, 32768
    s_nop 0
    buffer_load_dwordx4 v5, s[16:19], s96 offen offset:0 lds
    ds_read_b64_tr_b16 v[48:49], v8 offset:20480
    v_mfma_f32_16x16x32_bf16 v[20:23], v[104:107], v[204:207], v[20:23]
    ds_read_b64_tr_b16 v[50:51], v8 offset:20992
    ds_read_b64_tr_b16 v[52:53], v8 offset:28672
    v_mfma_f32_16x16x32_bf16 v[24:27], v[200:203], v[108:111], v[24:27]
    ds_read_b64_tr_b16 v[54:55], v8 offset:29184
    v_mfma_f32_16x16x32_bf16 v[28:31], v[204:207], v[108:111], v[28:31]
    s_add_u32 m0, s52, 114688
    s_nop 0
    buffer_load_dwordx4 v5, s[16:19], s97 offen offset:0 lds
    s_waitcnt vmcnt(6)
    s_barrier
    s_waitcnt lgkmcnt(0)
    ds_read_b128 v[224:227], v6 offset:57344
    ds_read_b128 v[228:231], v6 offset:59392
    v_mfma_f32_16x16x32_bf16 v[16:19], v[40:43], v[208:211], v[16:19]
    ds_read_b64_tr_b16 v[32:33], v8 offset:32768
    v_mfma_f32_16x16x32_bf16 v[20:23], v[40:43], v[212:215], v[20:23]
    ds_read_b64_tr_b16 v[34:35], v8 offset:33280
    s_add_u32 m0, s52, 122880
    s_nop 0
    buffer_load_dwordx4 v5, s[16:19], s98 offen offset:0 lds
    ds_read_b64_tr_b16 v[36:37], v8 offset:40960
    v_mfma_f32_16x16x32_bf16 v[24:27], v[208:211], v[44:47], v[24:27]
    ds_read_b64_tr_b16 v[38:39], v8 offset:41472
    v_mfma_f32_16x16x32_bf16 v[28:31], v[212:215], v[44:47], v[28:31]
    ds_read_b128 v[232:235], v7 offset:57344
    ds_read_b128 v[236:239], v7 offset:59392
    v_mfma_f32_16x16x32_bf16 v[16:19], v[48:51], v[216:219], v[16:19]
    s_add_u32 m0, s52, 40960
    s_nop 0
    buffer_load_dwordx4 v5, s[16:19], s99 offen offset:0 lds
    ds_read_b64_tr_b16 v[104:105], v8 offset:36864
    v_mfma_f32_16x16x32_bf16 v[20:23], v[48:51], v[220:223], v[20:23]
    ds_read_b64_tr_b16 v[106:107], v8 offset:37376
    ds_read_b64_tr_b16 v[108:109], v8 offset:45056
    v_mfma_f32_16x16x32_bf16 v[24:27], v[216:219], v[52:55], v[24:27]
    ds_read_b64_tr_b16 v[110:111], v8 offset:45568
    v_mfma_f32_16x16x32_bf16 v[28:31], v[220:223], v[52:55], v[28:31]
    s_waitcnt lgkmcnt(6)
    v_mfma_f32_16x16x32_bf16 v[16:19], v[32:35], v[224:227], v[16:19]
    v_mfma_f32_16x16x32_bf16 v[20:23], v[32:35], v[228:231], v[20:23]
    v_mfma_f32_16x16x32_bf16 v[24:27], v[224:227], v[36:39], v[24:27]
    v_mfma_f32_16x16x32_bf16 v[28:31], v[228:231], v[36:39], v[28:31]
    s_waitcnt lgkmcnt(0)
    v_mfma_f32_16x16x32_bf16 v[16:19], v[104:107], v[232:235], v[16:19]
    v_mfma_f32_16x16x32_bf16 v[20:23], v[104:107], v[236:239], v[20:23]
    v_mfma_f32_16x16x32_bf16 v[24:27], v[232:235], v[108:111], v[24:27]
    v_mfma_f32_16x16x32_bf16 v[28:31], v[236:239], v[108:111], v[28:31]
    v_add_u32 v10, s45, v246
    v_add_u32 v11, s45, v2
    v_add_u32 v12, s45, v9
    s_nop 4
    v_cvt_pk_bf16_f32 v40, v16, v17
    v_cvt_pk_bf16_f32 v41, v18, v19
    v_cvt_pk_bf16_f32 v42, v20, v21
    v_cvt_pk_bf16_f32 v43, v22, v23
    v_cvt_pk_bf16_f32 v44, v24, v25
    v_cvt_pk_bf16_f32 v45, v26, v27
    v_cvt_pk_bf16_f32 v46, v28, v29
    v_cvt_pk_bf16_f32 v47, v30, v31
    v_permlane16_swap_b32 v40, v42
    v_permlane16_swap_b32 v41, v43
    buffer_store_dwordx4 v[44:47], v2, s[20:23], s50 offen offset:1024 sc1
    buffer_store_dwordx4 v[40:43], v246, s[20:23], s50 offen sc1
    ds_write_b128 v11, v[44:47] offset:1024
    ds_write_b128 v10, v[40:43]
    s_waitcnt lgkmcnt(0)
    ds_read_b128 v[56:59], v11
    s_mov_b64 exec, s[48:49]
    ds_read_b128 v[60:63], v12
    ds_read_b128 v[64:67], v12 offset:512
    s_mov_b64 exec, -1
    s_waitcnt vmcnt(7)
    s_cmp_lg_u32 s42, 0
    s_cbranch_scc1 L_nf2
    s_mov_b32 s53, 65536
L_nspin:
    v_readfirstlane_b32 s54, v244
    s_sub_u32 s53, s53, 1
    s_cbranch_scc1 L_ngot
    s_cmp_lg_u32 s54, 0
    s_cbranch_scc1 L_ngot
    s_sleep 2
    buffer_load_dwordx2 v[244:245], off, s[32:35], 0 sc1
    s_waitcnt vmcnt(0)
    s_branch L_nspin
L_ngot:
    v_mov_b32 v10, 133888
    ds_write_b64 v10, v[244:245]
L_nf2:
    s_waitcnt lgkmcnt(0)
    s_barrier
    v_mov_b32 v10, 133888
    ds_read_b64 v[244:245], v10
    s_lshl_b32 s54, s41, 5
    s_add_u32 s53, s63, s54
    ds_read_b64_tr_b16 v[48:49], v249 offset:0
    ds_read_b64_tr_b16 v[50:51], v249 offset:512
    ds_read_b64_tr_b16 v[52:53], v249 offset:4096
    ds_read_b64_tr_b16 v[54:55], v249 offset:4608
    ds_read_b64_tr_b16 v[16:17], v249 offset:8192
    ds_read_b64_tr_b16 v[18:19], v249 offset:8704
    ds_read_b64_tr_b16 v[20:21], v249 offset:12288
    ds_read_b64_tr_b16 v[22:23], v249 offset:12800
    ds_read_b64_tr_b16 v[24:25], v249 offset:16384
    ds_read_b64_tr_b16 v[26:27], v249 offset:16896
    ds_read_b64_tr_b16 v[28:29], v249 offset:20480
    ds_read_b64_tr_b16 v[30:31], v249 offset:20992
    s_waitcnt lgkmcnt(10)
    v_readfirstlane_b32 s46, v244
    v_readfirstlane_b32 s47, v245
    v_mfma_f32_16x16x32_bf16 v[32:35], v[48:51], v[112:115], 0
    v_mfma_f32_16x16x32_bf16 v[36:39], v[48:51], v[116:119], 0
    s_waitcnt lgkmcnt(8)
    v_mfma_f32_16x16x32_bf16 v[32:35], v[52:55], v[120:123], v[32:35]
    v_mfma_f32_16x16x32_bf16 v[36:39], v[52:55], v[124:127], v[36:39]
    s_waitcnt lgkmcnt(6)
    v_mfma_f32_16x16x32_bf16 v[32:35], v[16:19], v[128:131], v[32:35]
    v_mfma_f32_16x16x32_bf16 v[36:39], v[16:19], v[132:135], v[36:39]
    v_mov_b32 v12, 0
    v_mov_b32 v13, 0
    v_mov_b32 v14, 0
    v_mov_b32 v15, 0
    s_waitcnt lgkmcnt(4)
    v_mfma_f32_16x16x32_bf16 v[32:35], v[20:23], v[136:139], v[32:35]
    v_mfma_f32_16x16x32_bf16 v[36:39], v[20:23], v[140:143], v[36:39]
    v_mfma_f32_32x32x16_bf16 v[112:127], v[12:15], v[12:15], 0
    v_mfma_f32_32x32x16_bf16 v[128:143], v[12:15], v[12:15], 0
    s_waitcnt lgkmcnt(2)
    v_mfma_f32_16x16x32_bf16 v[32:35], v[24:27], v[144:147], v[32:35]
    v_mfma_f32_16x16x32_bf16 v[36:39], v[24:27], v[148:151], v[36:39]
    s_waitcnt vmcnt(0)
    s_barrier
    s_cmp_lg_u32 s42, 0
    s_cbranch_scc1 L_nflag
    s_mov_b64 exec, 1
    buffer_store_dwordx2 v[244:245], off, s[20:23], s53 sc1
    s_mov_b64 exec, -1
L_nflag:
    ds_read_b64_tr_b16 v[40:41], v249 offset:24576
    ds_read_b64_tr_b16 v[42:43], v249 offset:25088
    ds_read_b64_tr_b16 v[44:45], v249 offset:28672
    ds_read_b64_tr_b16 v[46:47], v249 offset:29184
    ds_read_b64_tr_b16 v[48:49], v249 offset:32768
    ds_read_b64_tr_b16 v[50:51], v249 offset:33280
    ds_read_b64_tr_b16 v[52:53], v249 offset:36864
    ds_read_b64_tr_b16 v[54:55], v249 offset:37376
    ds_read_b64_tr_b16 v[16:17], v8 offset:49152
    ds_read_b64_tr_b16 v[18:19], v8 offset:49664
    s_waitcnt lgkmcnt(10)
    v_mfma_f32_16x16x32_bf16 v[32:35], v[28:31], v[152:155], v[32:35]
    v_mfma_f32_16x16x32_bf16 v[36:39], v[28:31], v[156:159], v[36:39]
    ds_read_b64_tr_b16 v[20:21], v8 offset:53248
    ds_read_b64_tr_b16 v[22:23], v8 offset:53760
    s_waitcnt lgkmcnt(10)
    v_mfma_f32_16x16x32_bf16 v[32:35], v[40:43], v[160:163], v[32:35]
    v_mfma_f32_16x16x32_bf16 v[36:39], v[40:43], v[164:167], v[36:39]
    ds_read_b64_tr_b16 v[24:25], v8 offset:57344
    ds_read_b64_tr_b16 v[26:27], v8 offset:57856
    s_waitcnt lgkmcnt(10)
    v_mfma_f32_16x16x32_bf16 v[32:35], v[44:47], v[168:171], v[32:35]
    v_mfma_f32_16x16x32_bf16 v[36:39], v[44:47], v[172:175], v[36:39]
    ds_read_b64_tr_b16 v[28:29], v8 offset:61440
    ds_read_b64_tr_b16 v[30:31], v8 offset:61952
    s_waitcnt lgkmcnt(10)
    v_mfma_f32_16x16x32_bf16 v[32:35], v[48:51], v[176:179], v[32:35]
    v_mfma_f32_16x16x32_bf16 v[36:39], v[48:51], v[180:183], v[36:39]
    ds_read_b64_tr_b16 v[40:41], v249 offset:40960
    ds_read_b64_tr_b16 v[42:43], v249 offset:41472
    s_waitcnt lgkmcnt(10)
    v_mfma_f32_16x16x32_bf16 v[32:35], v[52:55], v[184:187], v[32:35]
    v_mfma_f32_16x16x32_bf16 v[36:39], v[52:55], v[188:191], v[36:39]
    ds_read_b64_tr_b16 v[44:45], v249 offset:45056
    ds_read_b64_tr_b16 v[46:47], v249 offset:45568
    s_waitcnt lgkmcnt(10)
    v_mfma_f32_16x16x32_bf16 v[32:35], v[16:19], v[192:195], v[32:35]
    v_mfma_f32_16x16x32_bf16 v[36:39], v[16:19], v[196:199], v[36:39]
    s_waitcnt lgkmcnt(8)
    v_mfma_f32_16x16x32_bf16 v[32:35], v[20:23], v[200:203], v[32:35]
    v_mfma_f32_16x16x32_bf16 v[36:39], v[20:23], v[204:207], v[36:39]
    s_waitcnt lgkmcnt(6)
    v_mfma_f32_16x16x32_bf16 v[32:35], v[24:27], v[208:211], v[32:35]
    v_mfma_f32_16x16x32_bf16 v[36:39], v[24:27], v[212:215], v[36:39]
    s_waitcnt lgkmcnt(4)
    v_mfma_f32_16x16x32_bf16 v[32:35], v[28:31], v[216:219], v[32:35]
    v_mfma_f32_16x16x32_bf16 v[36:39], v[28:31], v[220:223], v[36:39]
    s_waitcnt lgkmcnt(2)
    v_mfma_f32_16x16x32_bf16 v[32:35], v[40:43], v[224:227], v[32:35]
    v_mfma_f32_16x16x32_bf16 v[36:39], v[40:43], v[228:231], v[36:39]
    s_waitcnt lgkmcnt(0)
    v_mfma_f32_16x16x32_bf16 v[32:35], v[44:47], v[232:235], v[32:35]
    v_mfma_f32_16x16x32_bf16 v[36:39], v[44:47], v[236:239], v[36:39]
    s_xor_b32 s53, s45, 16384
    s_mov_b32 s54, 0x3eb8aa3b
    v_add_u32 v10, s53, v2
    s_mov_b64 s[76:77], s[20:21]
    s_mov_b32 s78, s22
    s_mov_b32 s79, 0x00020000
    s_mov_b32 s67, 8
    s_nop 0
    v_pk_mul_f32 v[32:33], s[54:55], v[32:33] op_sel_hi:[0,1]
    v_pk_mul_f32 v[34:35], s[54:55], v[34:35] op_sel_hi:[0,1]
    v_pk_mul_f32 v[36:37], s[54:55], v[36:37] op_sel_hi:[0,1]
    v_pk_mul_f32 v[38:39], s[54:55], v[38:39] op_sel_hi:[0,1]
    v_cvt_pk_bf16_f32 v108, v32, v33
    v_cvt_pk_bf16_f32 v109, v34, v35
    v_cvt_pk_bf16_f32 v110, v36, v37
    v_cvt_pk_bf16_f32 v111, v38, v39
    s_nop 1
    v_permlane16_swap_b32 v108, v110
    v_permlane16_swap_b32 v109, v111
    ds_write_b128 v10, v[108:111] offset:3072
    s_mov_b32 s53, 65536
    v_mfma_f32_32x32x16_bf16 v[160:175], v[56:59], v[108:111], 0.15915494
    s_waitcnt lgkmcnt(0)
    s_barrier
    ds_read_b128 v[104:107], v11 offset:3072
    buffer_load_dwordx2 v[250:251], v242, s[20:23], s63 offen sc1
    s_nop 7
    v_exp_f32 v160, v160
    v_exp_f32 v161, v161
    v_exp_f32 v162, v162
    v_exp_f32 v163, v163
    s_waitcnt lgkmcnt(0)
    v_mfma_f32_32x32x16_bf16 v[144:159], v[56:59], v[104:107], 0.15915494
    v_exp_f32 v164, v164
    v_exp_f32 v165, v165
    v_exp_f32 v166, v166
    v_exp_f32 v167, v167
    v_exp_f32 v168, v168
    v_exp_f32 v169, v169
    v_smfmac_f32_32x32x32_bf16 v[128:143], v[60:63], v[160:167], v3
    v_exp_f32 v170, v170
    v_exp_f32 v171, v171
    v_exp_f32 v172, v172
    v_exp_f32 v173, v173
    v_exp_f32 v174, v174
    v_exp_f32 v175, v175
    s_waitcnt vmcnt(0)
    v_cmp_eq_u64 vcc, s[46:47], v[250:251]
    s_nop 1
    s_cmp_eq_u64 vcc, -1
    s_cbranch_scc0 L_late
    s_add_u32 s64, s64, 4096
    s_and_b32 s64, s64, 0x1ffff
    buffer_load_dwordx4 v[68:71], v247, s[76:79], s64 offen sc1
    s_mov_b64 exec, s[48:49]
    buffer_load_dwordx4 v[72:75], v248, s[76:79], s64 offen sc1
    buffer_load_dwordx4 v[76:79], v248, s[76:79], s64 offen offset:512 sc1
    s_mov_b64 exec, -1
    s_add_u32 s64, s64, 4096
    s_and_b32 s64, s64, 0x1ffff
    buffer_load_dwordx4 v[80:83], v247, s[76:79], s64 offen sc1
    s_mov_b64 exec, s[48:49]
    buffer_load_dwordx4 v[84:87], v248, s[76:79], s64 offen sc1
    buffer_load_dwordx4 v[88:91], v248, s[76:79], s64 offen offset:512 sc1
    s_mov_b64 exec, -1
    s_add_u32 s64, s64, 4096
    s_and_b32 s64, s64, 0x1ffff
    buffer_load_dwordx4 v[92:95], v247, s[76:79], s64 offen sc1
    s_mov_b64 exec, s[48:49]
    buffer_load_dwordx4 v[96:99], v248, s[76:79], s64 offen sc1
    buffer_load_dwordx4 v[100:103], v248, s[76:79], s64 offen offset:512 sc1
    s_mov_b64 exec, -1
    v_exp_f32 v144, v144
    v_exp_f32 v145, v145
    v_exp_f32 v146, v146
    v_exp_f32 v147, v147
    v_exp_f32 v148, v148
    v_exp_f32 v149, v149
    v_exp_f32 v150, v150
    v_exp_f32 v151, v151
    v_exp_f32 v152, v152
    v_exp_f32 v153, v153
    v_exp_f32 v154, v154
    v_smfmac_f32_32x32x32_bf16 v[112:127], v[60:63], v[144:151], v3
    v_exp_f32 v155, v155
    v_exp_f32 v156, v156
    v_exp_f32 v157, v157
    v_exp_f32 v158, v158
    v_exp_f32 v159, v159
    s_nop 1
    v_smfmac_f32_32x32x32_bf16 v[112:127], v[64:67], v[152:159], v3
    s_branch L_go
L_late:
    buffer_load_dwordx2 v[250:251], v242, s[20:23], s63 offen sc1
    v_exp_f32 v144, v144
    v_exp_f32 v145, v145
    v_exp_f32 v146, v146
    v_exp_f32 v147, v147
    v_exp_f32 v148, v148
    v_exp_f32 v149, v149
    v_exp_f32 v150, v150
    v_exp_f32 v151, v151
    v_exp_f32 v152, v152
    v_exp_f32 v153, v153
    v_exp_f32 v154, v154
    v_smfmac_f32_32x32x32_bf16 v[112:127], v[60:63], v[144:151], v3
    v_exp_f32 v155, v155
    v_exp_f32 v156, v156
    v_exp_f32 v157, v157
    v_exp_f32 v158, v158
    v_exp_f32 v159, v159
    s_nop 1
    v_smfmac_f32_32x32x32_bf16 v[112:127], v[64:67], v[152:159], v3
L_kvspin:
    s_waitcnt vmcnt(0)
    v_cmp_eq_u64 vcc, s[46:47], v[250:251]
    s_sub_u32 s53, s53, 1
    s_cbranch_scc1 L_kvgo
    s_cmp_eq_u64 vcc, -1
    s_cbranch_scc1 L_kvgo
    s_sleep 1
    buffer_load_dwordx2 v[250:251], v242, s[20:23], s63 offen sc1
    s_branch L_kvspin
L_kvgo:
    s_add_u32 s64, s64, 4096
    s_and_b32 s64, s64, 0x1ffff
    buffer_load_dwordx4 v[68:71], v247, s[76:79], s64 offen sc1
    s_mov_b64 exec, s[48:49]
    buffer_load_dwordx4 v[72:75], v248, s[76:79], s64 offen sc1
    buffer_load_dwordx4 v[76:79], v248, s[76:79], s64 offen offset:512 sc1
    s_mov_b64 exec, -1
    s_add_u32 s64, s64, 4096
    s_and_b32 s64, s64, 0x1ffff
    buffer_load_dwordx4 v[80:83], v247, s[76:79], s64 offen sc1
    s_mov_b64 exec, s[48:49]
    buffer_load_dwordx4 v[84:87], v248, s[76:79], s64 offen sc1
    buffer_load_dwordx4 v[88:91], v248, s[76:79], s64 offen offset:512 sc1
    s_mov_b64 exec, -1
    s_add_u32 s64, s64, 4096
    s_and_b32 s64, s64, 0x1ffff
    buffer_load_dwordx4 v[92:95], v247, s[76:79], s64 offen sc1
    s_mov_b64 exec, s[48:49]
    buffer_load_dwordx4 v[96:99], v248, s[76:79], s64 offen sc1
    buffer_load_dwordx4 v[100:103], v248, s[76:79], s64 offen offset:512 sc1
    s_mov_b64 exec, -1
L_go:
    v_lshrrev_b32 v12, 5, v0
    v_bfe_u32 v13, v0, 2, 3
    v_lshl_add_u32 v14, v12, 4, v13
    v_lshlrev_b32 v14, 8, v14
    s_lshl_b32 s54, s43, 1
    v_xor_b32 v13, s54, v13
    v_lshl_add_u32 v14, v13, 5, v14
    v_and_b32 v13, 3, v0
    v_lshl_add_u32 v16, v13, 3, v14
    v_add_u32 v17, 65536, v16
    v_xor_b32 v18, 32, v16
    v_xor_b32 v19, 32, v17
    v_and_b32 v10, 15, v0
    v_lshrrev_b32 v13, 4, v0
    v_lshlrev_b32 v14, 9, v13
    v_lshl_add_u32 v14, v10, 4, v14
    s_lshl_b32 s54, s44, 8
    s_add_u32 s54, s54, 131072
    v_add_u32 v20, s54, v14
    v_lshlrev_b32 v14, 10, v10
    v_lshl_add_u32 v14, v12, 4, v14
    v_and_b32 v13, 1, v13
    v_lshl_add_u32 v21, v13, 5, v14
    s_lshl_b32 s53, s40, 12
    s_lshl_b32 s54, s43, 10
    s_add_u32 s53, s53, s54
    s_add_u32 s53, s53, 131072
    v_add_u32 v22, s53, v2
    v_lshlrev_b32 v23, 7, v0
    s_xor_b32 s54, s45, 16384
    v_add_u32 v24, s54, v2
    v_lshlrev_b32 v14, 2, v0
    v_add_u32 v25, s54, v14
    v_add_u32 v26, s45, v14
    s_cmp_lg_u32 s44, 1
    s_cbranch_scc1 L_noprio
    s_setprio 1
L_noprio:
    s_waitcnt vmcnt(6)
    v_mfma_f32_32x32x16_bf16 v[144:159], v[68:71], v[104:107], 0.15915494
    s_nop 7
    s_nop 2
    s_branch L_loop1
.p2align 6
L_loop:
    v_exp_f32 v144, v144
    v_exp_f32 v145, v145
    v_smfmac_f32_32x32x32_bf16 v[128:143], v[100:103], v[168:175], v3
    v_exp_f32 v146, v146
    s_add_u32 s64, s64, 4096
    s_and_b32 s64, s64, 0x1ffff
    buffer_load_dwordx4 v[92:95], v247, s[76:79], s64 offen sc1
    v_exp_f32 v147, v147
    v_exp_f32 v148, v148
    v_mfma_f32_32x32x16_bf16 v[160:175], v[56:59], v[108:111], 0.15915494
    v_exp_f32 v149, v149
    v_exp_f32 v150, v150
    s_mov_b64 exec, s[48:49]
    buffer_load_dwordx4 v[96:99], v248, s[76:79], s64 offen sc1
    buffer_load_dwordx4 v[100:103], v248, s[76:79], s64 offen offset:512 sc1
    s_mov_b64 exec, -1
    v_exp_f32 v151, v151
    v_exp_f32 v152, v152
    v_exp_f32 v153, v153
    v_exp_f32 v154, v154
    v_smfmac_f32_32x32x32_bf16 v[112:127], v[60:63], v[144:151], v3
    v_exp_f32 v155, v155
    v_exp_f32 v156, v156
    v_exp_f32 v157, v157
    v_exp_f32 v158, v158
    v_exp_f32 v159, v159
    v_exp_f32 v160, v160
    v_exp_f32 v161, v161
    v_smfmac_f32_32x32x32_bf16 v[112:127], v[64:67], v[152:159], v3
    v_exp_f32 v162, v162
    v_exp_f32 v163, v163
    v_exp_f32 v164, v164
    s_waitcnt vmcnt(6)
    v_mfma_f32_32x32x16_bf16 v[144:159], v[68:71], v[104:107], 0.15915494
    v_exp_f32 v165, v165
    v_exp_f32 v166, v166
    v_exp_f32 v167, v167
    v_exp_f32 v168, v168
    v_exp_f32 v169, v169
    v_exp_f32 v170, v170
    v_smfmac_f32_32x32x32_bf16 v[128:143], v[60:63], v[160:167], v3
    v_exp_f32 v171, v171
    v_exp_f32 v172, v172
    v_exp_f32 v173, v173
    v_exp_f32 v174, v174
    v_exp_f32 v175, v175
L_loop1:
    s_cmp_lg_u32 s67, 2
    s_cbranch_scc1 L_nodrop
    s_setprio 0
    buffer_load_dwordx2 v[250:251], off, s[20:23], s75 sc1
L_nodrop:
    s_cmp_eq_u32 s67, 1
    s_cselect_b32 s78, 0, s78
    v_exp_f32 v144, v144
    v_exp_f32 v145, v145
    v_smfmac_f32_32x32x32_bf16 v[128:143], v[64:67], v[168:175], v3
    v_exp_f32 v146, v146
    s_add_u32 s64, s64, 4096
    s_and_b32 s64, s64, 0x1ffff
    buffer_load_dwordx4 v[56:59], v247, s[76:79], s64 offen sc1
    v_exp_f32 v147, v147
    v_exp_f32 v148, v148
    v_mfma_f32_32x32x16_bf16 v[160:175], v[68:71], v[108:111], 0.15915494
    v_exp_f32 v149, v149
    v_exp_f32 v150, v150
    s_mov_b64 exec, s[48:49]
    buffer_load_dwordx4 v[60:63], v248, s[76:79], s64 offen sc1
    buffer_load_dwordx4 v[64:67], v248, s[76:79], s64 offen offset:512 sc1
    s_mov_b64 exec, -1
    v_exp_f32 v151, v151
    v_exp_f32 v152, v152
    v_exp_f32 v153, v153
    v_exp_f32 v154, v154
    v_smfmac_f32_32x32x32_bf16 v[112:127], v[72:75], v[144:151], v3
    v_exp_f32 v155, v155
    v_exp_f32 v156, v156
    v_exp_f32 v157, v157
    v_exp_f32 v158, v158
    v_exp_f32 v159, v159
    v_exp_f32 v160, v160
    v_exp_f32 v161, v161
    v_smfmac_f32_32x32x32_bf16 v[112:127], v[76:79], v[152:159], v3
    v_exp_f32 v162, v162
    v_exp_f32 v163, v163
    v_exp_f32 v164, v164
    s_waitcnt vmcnt(6)
    v_mfma_f32_32x32x16_bf16 v[144:159], v[80:83], v[104:107], 0.15915494
    v_exp_f32 v165, v165
    v_exp_f32 v166, v166
    v_exp_f32 v167, v167
    v_exp_f32 v168, v168
    v_exp_f32 v169, v169
    v_exp_f32 v170, v170
    v_smfmac_f32_32x32x32_bf16 v[128:143], v[72:75], v[160:167], v3
    v_exp_f32 v171, v171
    v_exp_f32 v172, v172
    v_exp_f32 v173, v173
    v_exp_f32 v174, v174
    v_exp_f32 v175, v175
    v_exp_f32 v144, v144
    v_exp_f32 v145, v145
    v_smfmac_f32_32x32x32_bf16 v[128:143], v[76:79], v[168:175], v3
    v_exp_f32 v146, v146
    s_add_u32 s64, s64, 4096
    s_and_b32 s64, s64, 0x1ffff
    buffer_load_dwordx4 v[68:71], v247, s[76:79], s64 offen sc1
    v_exp_f32 v147, v147
    v_exp_f32 v148, v148
    v_mfma_f32_32x32x16_bf16 v[160:175], v[80:83], v[108:111], 0.15915494
    v_exp_f32 v149, v149
    v_exp_f32 v150, v150
    s_mov_b64 exec, s[48:49]
    buffer_load_dwordx4 v[72:75], v248, s[76:79], s64 offen sc1
    buffer_load_dwordx4 v[76:79], v248, s[76:79], s64 offen offset:512 sc1
    s_mov_b64 exec, -1
    v_exp_f32 v151, v151
    v_exp_f32 v152, v152
    v_exp_f32 v153, v153
    v_exp_f32 v154, v154
    v_smfmac_f32_32x32x32_bf16 v[112:127], v[84:87], v[144:151], v3
    v_exp_f32 v155, v155
    v_exp_f32 v156, v156
    v_exp_f32 v157, v157
    v_exp_f32 v158, v158
    v_exp_f32 v159, v159
    v_exp_f32 v160, v160
    v_exp_f32 v161, v161
    v_smfmac_f32_32x32x32_bf16 v[112:127], v[88:91], v[152:159], v3
    v_exp_f32 v162, v162
    v_exp_f32 v163, v163
    v_exp_f32 v164, v164
    s_waitcnt vmcnt(6)
    v_mfma_f32_32x32x16_bf16 v[144:159], v[92:95], v[104:107], 0.15915494
    v_exp_f32 v165, v165
    v_exp_f32 v166, v166
    v_exp_f32 v167, v167
    v_exp_f32 v168, v168
    v_exp_f32 v169, v169
    v_exp_f32 v170, v170
    v_smfmac_f32_32x32x32_bf16 v[128:143], v[84:87], v[160:167], v3
    v_exp_f32 v171, v171
    v_exp_f32 v172, v172
    v_exp_f32 v173, v173
    v_exp_f32 v174, v174
    v_exp_f32 v175, v175
    v_exp_f32 v144, v144
    v_exp_f32 v145, v145
    v_smfmac_f32_32x32x32_bf16 v[128:143], v[88:91], v[168:175], v3
    v_exp_f32 v146, v146
    s_add_u32 s64, s64, 4096
    s_and_b32 s64, s64, 0x1ffff
    buffer_load_dwordx4 v[80:83], v247, s[76:79], s64 offen sc1
    v_exp_f32 v147, v147
    v_exp_f32 v148, v148
    v_mfma_f32_32x32x16_bf16 v[160:175], v[92:95], v[108:111], 0.15915494
    v_exp_f32 v149, v149
    v_exp_f32 v150, v150
    s_mov_b64 exec, s[48:49]
    buffer_load_dwordx4 v[84:87], v248, s[76:79], s64 offen sc1
    buffer_load_dwordx4 v[88:91], v248, s[76:79], s64 offen offset:512 sc1
    s_mov_b64 exec, -1
    v_exp_f32 v151, v151
    v_exp_f32 v152, v152
    v_exp_f32 v153, v153
    v_exp_f32 v154, v154
    v_smfmac_f32_32x32x32_bf16 v[112:127], v[96:99], v[144:151], v3
    v_exp_f32 v155, v155
    v_exp_f32 v156, v156
    v_exp_f32 v157, v157
    v_exp_f32 v158, v158
    v_exp_f32 v159, v159
    v_exp_f32 v160, v160
    v_exp_f32 v161, v161
    v_smfmac_f32_32x32x32_bf16 v[112:127], v[100:103], v[152:159], v3
    v_exp_f32 v162, v162
    v_exp_f32 v163, v163
    v_exp_f32 v164, v164
    s_waitcnt vmcnt(6)
    v_mfma_f32_32x32x16_bf16 v[144:159], v[56:59], v[104:107], 0.15915494
    v_exp_f32 v165, v165
    v_exp_f32 v166, v166
    v_exp_f32 v167, v167
    v_exp_f32 v168, v168
    v_exp_f32 v169, v169
    v_exp_f32 v170, v170
    v_smfmac_f32_32x32x32_bf16 v[128:143], v[96:99], v[160:167], v3
    v_exp_f32 v171, v171
    v_exp_f32 v172, v172
    v_exp_f32 v173, v173
    s_cmp_lg_u32 s67, 1
    s_cbranch_scc1 L_nopart
    ds_write_b128 v24, v[112:115]
    ds_write_b128 v24, v[116:119] offset:1024
    ds_write_b32 v25, v120 offset:2048
L_nopart:
    v_exp_f32 v174, v174
    v_exp_f32 v175, v175
    s_cmp_le_u32 s67, 4
    s_cbranch_scc1 L_nowo
    s_add_u32 m0, s65, s52
    s_add_u32 s65, s65, 8192
    buffer_load_dwordx4 v240, s[24:27], s66 offen lds
    s_and_b32 s65, s65, 0x1ffff
    s_lshl_b32 s66, s65, 2
    s_add_u32 m0, s65, s52
    s_add_u32 s65, s65, 8192
    buffer_load_dwordx4 v240, s[24:27], s66 offen lds
    s_and_b32 s65, s65, 0x1ffff
    s_lshl_b32 s66, s65, 2
    s_add_u32 m0, s65, s52
    s_add_u32 s65, s65, 8192
    buffer_load_dwordx4 v240, s[24:27], s66 offen lds
    s_and_b32 s65, s65, 0x1ffff
    s_lshl_b32 s66, s65, 2
    s_add_u32 m0, s65, s52
    s_add_u32 s65, s65, 8192
    buffer_load_dwordx4 v240, s[24:27], s66 offen lds
    s_and_b32 s65, s65, 0x1ffff
    s_lshl_b32 s66, s65, 2
L_nowo:
    s_sub_u32 s67, s67, 1
    s_cmp_lg_u32 s67, 0
    s_cbranch_scc1 L_loop
    v_smfmac_f32_32x32x32_bf16 v[128:143], v[100:103], v[168:175], v3
    s_lshl_b32 s54, s60, 15
    s_lshl_b32 s55, s42, 12
    s_add_u32 s54, s54, s55
    s_add_u32 s64, s54, 0x500000
    s_waitcnt vmcnt(0) lgkmcnt(0)
    s_barrier
    ds_read_b32 v152, v26 offset:2048
    ds_read_b128 v[144:147], v11
    ds_read_b128 v[148:151], v11 offset:1024
    v_mov_b32 v13, 0x35800000
    v_mov_b32 v1, 0x5d800000
    s_nop 0
    s_waitcnt lgkmcnt(2)
    v_add_f32 v136, v136, v152
    v_rcp_f32 v14, v136
    s_waitcnt lgkmcnt(0)
    v_pk_add_f32 v[128:129], v[128:129], v[144:145]
    v_pk_add_f32 v[130:131], v[130:131], v[146:147]
    v_pk_add_f32 v[132:133], v[132:133], v[148:149]
    v_pk_add_f32 v[134:135], v[134:135], v[150:151]
    v_pk_mul_f32 v[144:145], v[14:15], v[128:129] op_sel_hi:[0,1]
    v_pk_mul_f32 v[146:147], v[14:15], v[130:131] op_sel_hi:[0,1]
    v_pk_mul_f32 v[148:149], v[14:15], v[132:133] op_sel_hi:[0,1]
    v_pk_mul_f32 v[150:151], v[14:15], v[134:135] op_sel_hi:[0,1]
    v_cvt_pk_bf16_f32 v40, v144, v145
    v_cvt_pk_bf16_f32 v41, v146, v147
    v_cvt_pk_bf16_f32 v42, v148, v149
    v_cvt_pk_bf16_f32 v43, v150, v151
    buffer_store_dwordx4 v[40:43], v2, s[20:23], s58 offen sc1
    v_cmp_ge_f32 s[68:69], v136, v13
    v_cmp_le_f32 s[70:71], v136, v1
    v_mul_f32 v14, 0, v128
    v_fma_f32 v14, v129, 0, v14
    v_fma_f32 v14, v130, 0, v14
    v_fma_f32 v14, v131, 0, v14
    v_fma_f32 v14, v132, 0, v14
    v_fma_f32 v14, v133, 0, v14
    v_fma_f32 v14, v134, 0, v14
    v_fma_f32 v14, v135, 0, v14
    v_cmp_o_f32 vcc, v14, v14
    s_and_b64 s[68:69], s[68:69], s[70:71]
    s_nop 1
    s_and_b64 s[68:69], s[68:69], vcc
    s_cmp_eq_u64 s[68:69], -1
    s_cbranch_scc0 L_fallback
L_fin:
    ds_read_b64_tr_b16 v[172:173], v17 offset:57344
    ds_read_b64_tr_b16 v[174:175], v17 offset:59392
    ds_read_b64_tr_b16 v[236:237], v19 offset:57344
    ds_read_b64_tr_b16 v[238:239], v19 offset:59392
    ds_read_b64_tr_b16 v[168:169], v17 offset:49152
    ds_read_b64_tr_b16 v[170:171], v17 offset:51200
    ds_read_b64_tr_b16 v[232:233], v19 offset:49152
    ds_read_b64_tr_b16 v[234:235], v19 offset:51200
    ds_read_b64_tr_b16 v[164:165], v17 offset:40960
    ds_read_b64_tr_b16 v[166:167], v17 offset:43008
    ds_read_b64_tr_b16 v[228:229], v19 offset:40960
    ds_read_b64_tr_b16 v[230:231], v19 offset:43008
    ds_read_b64_tr_b16 v[160:161], v17 offset:32768
    ds_read_b64_tr_b16 v[162:163], v17 offset:34816
    s_waitcnt lgkmcnt(2)
    ds_read_b64_tr_b16 v[224:225], v19 offset:32768
    ds_read_b64_tr_b16 v[226:227], v19 offset:34816
    ds_read_b64_tr_b16 v[156:157], v17 offset:24576
    ds_read_b64_tr_b16 v[158:159], v17 offset:26624
    ds_read_b64_tr_b16 v[220:221], v19 offset:24576
    ds_read_b64_tr_b16 v[222:223], v19 offset:26624
    ds_read_b64_tr_b16 v[152:153], v17 offset:16384
    ds_read_b64_tr_b16 v[154:155], v17 offset:18432
    ds_read_b64_tr_b16 v[216:217], v19 offset:16384
    ds_read_b64_tr_b16 v[218:219], v19 offset:18432
    ds_read_b64_tr_b16 v[148:149], v17 offset:8192
    ds_read_b64_tr_b16 v[150:151], v17 offset:10240
    s_waitcnt vmcnt(0)
    s_barrier
    s_cmp_lg_u32 s42, s40
    s_cbranch_scc1 L_noflag
    s_mov_b64 exec, 0xff
    buffer_store_dwordx2 v[244:245], v23, s[20:23], s74 offen sc1
    s_mov_b64 exec, -1
    s_branch L_flagged
L_noflag:
    buffer_load_dwordx2 v[250:251], off, s[20:23], s75 sc1
L_flagged:
    s_lshr_b32 s53, s40, 2
    s_cmp_lg_u32 s53, s44
    s_waitcnt lgkmcnt(0)
    s_cbranch_scc1 L_noown
    ds_write_b128 v22, v[40:43]
L_noown:
    ds_read_b64_tr_b16 v[212:213], v19 offset:8192
    ds_read_b64_tr_b16 v[214:215], v19 offset:10240
    ds_read_b64_tr_b16 v[144:145], v17 offset:0
    ds_read_b64_tr_b16 v[146:147], v17 offset:2048
    ds_read_b64_tr_b16 v[208:209], v19 offset:0
    ds_read_b64_tr_b16 v[210:211], v19 offset:2048
    ds_read_b64_tr_b16 v[140:141], v16 offset:57344
    ds_read_b64_tr_b16 v[142:143], v16 offset:59392
    ds_read_b64_tr_b16 v[204:205], v18 offset:57344
    ds_read_b64_tr_b16 v[206:207], v18 offset:59392
    ds_read_b64_tr_b16 v[136:137], v16 offset:49152
    ds_read_b64_tr_b16 v[138:139], v16 offset:51200
    ds_read_b64_tr_b16 v[200:201], v18 offset:49152
    ds_read_b64_tr_b16 v[202:203], v18 offset:51200
    s_waitcnt lgkmcnt(2)
    ds_read_b64_tr_b16 v[132:133], v16 offset:40960
    ds_read_b64_tr_b16 v[134:135], v16 offset:43008
    ds_read_b64_tr_b16 v[196:197], v18 offset:40960
    ds_read_b64_tr_b16 v[198:199], v18 offset:43008
    ds_read_b64_tr_b16 v[128:129], v16 offset:32768
    ds_read_b64_tr_b16 v[130:131], v16 offset:34816
    ds_read_b64_tr_b16 v[192:193], v18 offset:32768
    ds_read_b64_tr_b16 v[194:195], v18 offset:34816
    ds_read_b64_tr_b16 v[124:125], v16 offset:24576
    ds_read_b64_tr_b16 v[126:127], v16 offset:26624
    ds_read_b64_tr_b16 v[188:189], v18 offset:24576
    ds_read_b64_tr_b16 v[190:191], v18 offset:26624
    s_mov_b32 m0, s45
    s_waitcnt lgkmcnt(2)
    ds_read_b64_tr_b16 v[120:121], v16 offset:16384
    ds_read_b64_tr_b16 v[122:123], v16 offset:18432
    ds_read_b64_tr_b16 v[184:185], v18 offset:16384
    ds_read_b64_tr_b16 v[186:187], v18 offset:18432
    ds_read_b64_tr_b16 v[116:117], v16 offset:8192
    ds_read_b64_tr_b16 v[118:119], v16 offset:10240
    ds_read_b64_tr_b16 v[180:181], v18 offset:8192
    ds_read_b64_tr_b16 v[182:183], v18 offset:10240
    ds_read_b64_tr_b16 v[112:113], v16 offset:0
    ds_read_b64_tr_b16 v[114:115], v16 offset:2048
    ds_read_b64_tr_b16 v[176:177], v18 offset:0
    ds_read_b64_tr_b16 v[178:179], v18 offset:2048
    s_mov_b32 s53, 65536
    s_cmp_eq_u32 s42, s40
    s_cbranch_scc1 L_oskip
    s_branch L_ochk
L_ospin:
    buffer_load_dwordx2 v[250:251], off, s[20:23], s75 sc1
L_ochk:
    s_waitcnt vmcnt(0)
    v_cmp_eq_u64 vcc, s[46:47], v[250:251]
    s_sub_u32 s53, s53, 1
    s_cbranch_scc1 L_ogo
    s_cmp_eq_u64 vcc, -1
    s_cbranch_scc0 L_ospin
L_ogo:
    buffer_load_dwordx4 v2, s[20:23], s64 offen offset:0 sc1 lds
    buffer_load_dwordx4 v2, s[20:23], s64 offen offset:1024 sc1 lds
    buffer_load_dwordx4 v2, s[20:23], s64 offen offset:2048 sc1 lds
    buffer_load_dwordx4 v2, s[20:23], s64 offen offset:3072 sc1 lds
    s_waitcnt vmcnt(0)
L_oskip:
    s_waitcnt lgkmcnt(0)
    s_barrier
    ds_read_b128 v[44:47], v20 offset:0
    ds_read_b128 v[48:51], v20 offset:2048
    ds_read_b128 v[52:55], v20 offset:4096
    ds_read_b128 v[56:59], v20 offset:6144
    ds_read_b128 v[60:63], v20 offset:8192
    ds_read_b128 v[64:67], v20 offset:10240
    ds_read_b128 v[68:71], v20 offset:12288
    ds_read_b128 v[72:75], v20 offset:14336
    s_waitcnt lgkmcnt(7)
    v_mfma_f32_16x16x32_bf16 v[32:35], v[112:115], v[44:47], 0
    v_mfma_f32_16x16x32_bf16 v[36:39], v[176:179], v[44:47], 0
    ds_read_b128 v[44:47], v20 offset:16384
    s_waitcnt lgkmcnt(7)
    v_mfma_f32_16x16x32_bf16 v[32:35], v[116:119], v[48:51], v[32:35]
    v_mfma_f32_16x16x32_bf16 v[36:39], v[180:183], v[48:51], v[36:39]
    ds_read_b128 v[48:51], v20 offset:18432
    s_waitcnt lgkmcnt(7)
    v_mfma_f32_16x16x32_bf16 v[32:35], v[120:123], v[52:55], v[32:35]
    v_mfma_f32_16x16x32_bf16 v[36:39], v[184:187], v[52:55], v[36:39]
    ds_read_b128 v[52:55], v20 offset:20480
    s_waitcnt lgkmcnt(7)
    v_mfma_f32_16x16x32_bf16 v[32:35], v[124:127], v[56:59], v[32:35]
    v_mfma_f32_16x16x32_bf16 v[36:39], v[188:191], v[56:59], v[36:39]
    ds_read_b128 v[56:59], v20 offset:22528
    s_waitcnt lgkmcnt(7)
    v_mfma_f32_16x16x32_bf16 v[32:35], v[128:131], v[60:63], v[32:35]
    v_mfma_f32_16x16x32_bf16 v[36:39], v[192:195], v[60:63], v[36:39]
    ds_read_b128 v[60:63], v20 offset:24576
    s_waitcnt lgkmcnt(7)
    v_mfma_f32_16x16x32_bf16 v[32:35], v[132:135], v[64:67], v[32:35]
    v_mfma_f32_16x16x32_bf16 v[36:39], v[196:199], v[64:67], v[36:39]
    ds_read_b128 v[64:67], v20 offset:26624
    s_waitcnt lgkmcnt(7)
    v_mfma_f32_16x16x32_bf16 v[32:35], v[136:139], v[68:71], v[32:35]
    v_mfma_f32_16x16x32_bf16 v[36:39], v[200:203], v[68:71], v[36:39]
    ds_read_b128 v[68:71], v20 offset:28672
    s_waitcnt lgkmcnt(7)
    v_mfma_f32_16x16x32_bf16 v[32:35], v[140:143], v[72:75], v[32:35]
    v_mfma_f32_16x16x32_bf16 v[36:39], v[204:207], v[72:75], v[36:39]
    ds_read_b128 v[72:75], v20 offset:30720
    s_waitcnt lgkmcnt(7)
    v_mfma_f32_16x16x32_bf16 v[32:35], v[144:147], v[44:47], v[32:35]
    v_mfma_f32_16x16x32_bf16 v[36:39], v[208:211], v[44:47], v[36:39]
    s_waitcnt lgkmcnt(6)
    v_mfma_f32_16x16x32_bf16 v[32:35], v[148:151], v[48:51], v[32:35]
    v_mfma_f32_16x16x32_bf16 v[36:39], v[212:215], v[48:51], v[36:39]
    s_waitcnt lgkmcnt(5)
    v_mfma_f32_16x16x32_bf16 v[32:35], v[152:155], v[52:55], v[32:35]
    v_mfma_f32_16x16x32_bf16 v[36:39], v[216:219], v[52:55], v[36:39]
    s_waitcnt lgkmcnt(4)
    v_mfma_f32_16x16x32_bf16 v[32:35], v[156:159], v[56:59], v[32:35]
    v_mfma_f32_16x16x32_bf16 v[36:39], v[220:223], v[56:59], v[36:39]
    s_waitcnt lgkmcnt(3)
    v_mfma_f32_16x16x32_bf16 v[32:35], v[160:163], v[60:63], v[32:35]
    v_mfma_f32_16x16x32_bf16 v[36:39], v[224:227], v[60:63], v[36:39]
    s_waitcnt lgkmcnt(2)
    v_mfma_f32_16x16x32_bf16 v[32:35], v[164:167], v[64:67], v[32:35]
    v_mfma_f32_16x16x32_bf16 v[36:39], v[228:231], v[64:67], v[36:39]
    s_waitcnt lgkmcnt(1)
    v_mfma_f32_16x16x32_bf16 v[32:35], v[168:171], v[68:71], v[32:35]
    v_mfma_f32_16x16x32_bf16 v[36:39], v[232:235], v[68:71], v[36:39]
    s_waitcnt lgkmcnt(0)
    v_mfma_f32_16x16x32_bf16 v[32:35], v[172:175], v[72:75], v[32:35]
    v_mfma_f32_16x16x32_bf16 v[36:39], v[236:239], v[72:75], v[36:39]
    s_nop 7
    v_cvt_pk_bf16_f32 v40, v32, v33
    v_cvt_pk_bf16_f32 v41, v34, v35
    v_cvt_pk_bf16_f32 v42, v36, v37
    v_cvt_pk_bf16_f32 v43, v38, v39
    s_nop 1
    v_permlane16_swap_b32 v40, v42
    v_permlane16_swap_b32 v41, v43
    buffer_store_dwordx4 v[40:43], v21, s[28:31], s62 offen nt
L_end:
    s_endpgm
L_fallback:
    s_mul_i32 s53, s56, 131072
    s_mov_b32 s54, 0
    v_mov_b32 v14, 0xff800000
L_fb1:
    buffer_load_dwordx4 v[56:59], v2, s[20:23], s53 offen sc1
    s_waitcnt vmcnt(0)
    v_mfma_f32_32x32x16_bf16 v[160:175], v[56:59], v[108:111], 0
    s_add_u32 s53, s53, 2048
    s_add_u32 s54, s54, 1
    s_nop 7
    s_nop 3
    v_max3_f32 v14, v160, v161, v14
    v_max3_f32 v14, v162, v163, v14
    v_max3_f32 v14, v164, v165, v14
    v_max3_f32 v14, v166, v167, v14
    v_max3_f32 v14, v168, v169, v14
    v_max3_f32 v14, v170, v171, v14
    v_max3_f32 v14, v172, v173, v14
    v_max3_f32 v14, v174, v175, v14
    s_cmp_lt_u32 s54, 64
    s_cbranch_scc1 L_fb1
    v_mov_b32 v1, v14
    s_nop 1
    v_permlane32_swap_b32 v14, v1
    s_nop 1
    v_max_f32 v14, v14, v1
    v_sub_f32 v144, 0, v14
    v_sub_f32 v145, 0, v14
    v_sub_f32 v146, 0, v14
    v_sub_f32 v147, 0, v14
    v_sub_f32 v148, 0, v14
    v_sub_f32 v149, 0, v14
    v_sub_f32 v150, 0, v14
    v_sub_f32 v151, 0, v14
    v_sub_f32 v152, 0, v14
    v_sub_f32 v153, 0, v14
    v_sub_f32 v154, 0, v14
    v_sub_f32 v155, 0, v14
    v_sub_f32 v156, 0, v14
    v_sub_f32 v157, 0, v14
    v_sub_f32 v158, 0, v14
    v_sub_f32 v159, 0, v14
    v_mov_b32 v128, 0
    v_mov_b32 v129, 0
    v_mov_b32 v130, 0
    v_mov_b32 v131, 0
    v_mov_b32 v132, 0
    v_mov_b32 v133, 0
    v_mov_b32 v134, 0
    v_mov_b32 v135, 0
    v_mov_b32 v136, 0
    v_mov_b32 v137, 0
    v_mov_b32 v138, 0
    v_mov_b32 v139, 0
    v_mov_b32 v140, 0
    v_mov_b32 v141, 0
    v_mov_b32 v142, 0
    v_mov_b32 v143, 0
    s_mul_i32 s53, s56, 131072
    s_mov_b32 s54, 0
L_fb2:
    buffer_load_dwordx4 v[56:59], v2, s[20:23], s53 offen sc1
    s_mov_b64 exec, s[48:49]
    buffer_load_dwordx4 v[60:63], v9, s[20:23], s53 offen sc1
    buffer_load_dwordx4 v[64:67], v9, s[20:23], s53 offen offset:512 sc1
    s_mov_b64 exec, -1
    s_waitcnt vmcnt(0)
    v_mfma_f32_32x32x16_bf16 v[160:175], v[56:59], v[108:111], v[144:159]
    s_add_u32 s53, s53, 2048
    s_add_u32 s54, s54, 1
    s_nop 7
    s_nop 3
    v_exp_f32 v160, v160
    v_exp_f32 v161, v161
    v_exp_f32 v162, v162
    v_exp_f32 v163, v163
    v_exp_f32 v164, v164
    v_exp_f32 v165, v165
    v_exp_f32 v166, v166
    v_exp_f32 v167, v167
    v_exp_f32 v168, v168
    v_exp_f32 v169, v169
    v_exp_f32 v170, v170
    v_exp_f32 v171, v171
    v_exp_f32 v172, v172
    v_exp_f32 v173, v173
    v_exp_f32 v174, v174
    v_exp_f32 v175, v175
    s_nop 1
    v_smfmac_f32_32x32x32_bf16 v[128:143], v[60:63], v[160:167], v3
    v_smfmac_f32_32x32x32_bf16 v[128:143], v[64:67], v[168:175], v3
    s_cmp_lt_u32 s54, 64
    s_cbranch_scc1 L_fb2
    s_nop 7
    s_nop 7
    v_rcp_f32 v14, v136
    s_nop 0
    v_pk_mul_f32 v[144:145], v[14:15], v[128:129] op_sel_hi:[0,1]
    v_pk_mul_f32 v[146:147], v[14:15], v[130:131] op_sel_hi:[0,1]
    v_pk_mul_f32 v[148:149], v[14:15], v[132:133] op_sel_hi:[0,1]
    v_pk_mul_f32 v[150:151], v[14:15], v[134:135] op_sel_hi:[0,1]
    v_cvt_pk_bf16_f32 v40, v144, v145
    v_cvt_pk_bf16_f32 v41, v146, v147
    v_cvt_pk_bf16_f32 v42, v148, v149
    v_cvt_pk_bf16_f32 v43, v150, v151
    buffer_store_dwordx4 v[40:43], v2, s[20:23], s58 offen sc1
    s_branch L_fin
L_codeend:
.section .rodata,"a"
.p2align 6
.amdhsa_kernel standalone__mha_block__prompt_kernel
  .amdhsa_next_free_vgpr 256
  .amdhsa_next_free_sgpr 100
  .amdhsa_accum_offset 256
  .amdhsa_group_segment_fixed_size 0
  .amdhsa_kernarg_size 48
  .amdhsa_user_sgpr_count 2
  .amdhsa_user_sgpr_kernarg_segment_ptr 1
  .amdhsa_system_sgpr_workgroup_id_x 1
.end_amdhsa_kernel
```
